```python
import torch

def _softmax(x, axis=-1):
    return torch.softmax(x, dim=axis)
def _gelu(x):
    return torch.nn.functional.gelu(x, approximate="tanh")
def _silu(x):
    return torch.nn.functional.silu(x)
def _sigmoid(x):
    return torch.sigmoid(x)
def _layernorm(x, axis=-1, eps=1e-5):
    m = x.mean(dim=axis, keepdim=True)
    v = x.var(dim=axis, keepdim=True, unbiased=False)
    return (x - m) / torch.sqrt(v + eps)
def _scatter_add(tgt, idx, src, axis=0):
    return tgt.clone().index_add_(axis, idx, src)
def _segment_sum(src, seg, n):
    out = torch.zeros((n,) + src.shape[1:], dtype=src.dtype)
    return out.index_add_(0, seg, src)
def _pad(x, pw):
    flat = tuple(v for pair in reversed(pw) for v in pair)
    return torch.nn.functional.pad(x, flat)

kernel_name = 'standalone__self_sup_conv_stem_hubert__speech'

def setup_inputs():

    _w = (lambda a: (lambda t: t.to(torch.bfloat16) if t.is_floating_point() else t)(torch.as_tensor(a)))
    B, T, D, K = 2, 4000, 512, 15
    scale = (1.0 / (K * D)) ** 0.5
    return {
        "x": _w((lambda *s: torch.randn(*s, dtype=torch.bfloat16) * 0.05)(B, T, D)),
        "w": _w((lambda *s: torch.randn(*s, dtype=torch.bfloat16) * 0.05)(K, D, D) * scale),
        "b": _w((lambda *s: torch.randn(*s, dtype=torch.bfloat16) * 0.05)(D) * 0.1),
        "gamma": _w(torch.ones((D,), dtype=float)),
        "beta": _w(torch.zeros((D,), dtype=float)),
    }

def reference(x, w, b, gamma, beta):
    B, T, D = x.shape
    K = w.shape[0]
    s = 2
    L = (T - K) // s + 1
    y = torch.einsum('blc,cd->bld', x[:, 0 : s * L : s, :], w[0])
    for i in range(1, K):
        y = y + torch.einsum('blc,cd->bld', x[:, i : i + s * L : s, :], w[i])
    y = y + b[None, None, :]
    mu = y.mean(1, keepdims=True)
    var = ((y - mu) ** 2).mean(1, keepdims=True)
    yn = (y - mu) / torch.sqrt(var + 1e-5)
    yn = yn * gamma[None, None, :] + beta[None, None, :]
    return _gelu(yn)
```

```asm
; @launch grid=(256,1,1) block=(512,1,1) lds=157696
.amdgcn_target "amdgcn-amd-amdhsa--gfx950"
.text
.globl standalone__self_sup_conv_stem_hubert__speech_kernel
.p2align 8
.type standalone__self_sup_conv_stem_hubert__speech_kernel,@function
standalone__self_sup_conv_stem_hubert__speech_kernel:
    s_cmp_ge_u32 s2, 256
    s_cbranch_scc1 L_end
    s_load_dwordx4 s[4:7], s[0:1], 0
    s_load_dwordx4 s[8:11], s[0:1], 16
    s_load_dwordx4 s[12:15], s[0:1], 32
    s_load_dwordx4 s[16:19], s[0:1], 48
    s_and_b32 s24, s2, 7
    s_lshr_b32 s25, s2, 3
    s_lshr_b32 s20, s24, 2
    s_and_b32 s21, s24, 3
    s_lshl_b32 s21, s21, 1
    s_and_b32 s26, s25, 1
    s_add_u32 s21, s21, s26
    s_lshr_b32 s22, s25, 1
    v_lshrrev_b32 v1, 6, v0
    v_and_b32 v0, 63, v0
    s_nop 0
    v_readfirstlane_b32 s23, v1
    s_mov_b32 s26, 0xa77102c2
    s_mov_b32 s27, 0x2f30b
    s_cmp_lt_u32 s23, 4
    s_cbranch_scc1 L_consumer
L_producer:
    s_sub_u32 s24, s23, 4
    v_lshrrev_b32 v10, 3, v0
    v_and_b32 v11, 7, v0
    v_and_b32 v12, 2, v10
    s_and_b32 s25, s24, 1
    s_lshl_b32 s25, s25, 2
    v_or_b32 v12, s25, v12
    v_xor_b32 v12, v12, v11
    s_lshl_b32 s25, s24, 3
    v_add_u32 v13, s25, v10
    v_lshlrev_b32 v13, 10, v13
    v_lshl_add_u32 v2, v12, 4, v13
    s_lshl_b32 s25, s24, 1
    v_add_u32 v12, 0, v10
    v_cmp_le_u32 vcc, 17, v12
    v_subrev_u32 v13, 17, v12
    v_mov_b32 v14, s25
    v_cndmask_b32 v12, v12, v13, vcc
    v_addc_co_u32 v14, vcc, 0, v14, vcc
    v_mul_u32_u24 v16, 3, v12
    v_lshrrev_b64 v[16:17], v16, s[26:27]
    v_and_b32 v16, 7, v16
    v_xor_b32 v16, v16, v11
    v_lshl_add_u32 v12, v12, 3, v14
    v_lshlrev_b32 v12, 11, v12
    v_lshl_add_u32 v3, v16, 4, v12
    v_add_u32 v12, 8, v10
    v_cmp_le_u32 vcc, 17, v12
    v_subrev_u32 v13, 17, v12
    v_mov_b32 v14, s25
    v_cndmask_b32 v12, v12, v13, vcc
    v_addc_co_u32 v14, vcc, 0, v14, vcc
    v_mul_u32_u24 v16, 3, v12
    v_lshrrev_b64 v[16:17], v16, s[26:27]
    v_and_b32 v16, 7, v16
    v_xor_b32 v16, v16, v11
    v_lshl_add_u32 v12, v12, 3, v14
    v_lshlrev_b32 v12, 11, v12
    v_lshl_add_u32 v4, v16, 4, v12
    v_add_u32 v12, 16, v10
    v_cmp_le_u32 vcc, 17, v12
    v_subrev_u32 v13, 17, v12
    v_mov_b32 v14, s25
    v_cndmask_b32 v12, v12, v13, vcc
    v_addc_co_u32 v14, vcc, 0, v14, vcc
    v_mul_u32_u24 v16, 3, v12
    v_lshrrev_b64 v[16:17], v16, s[26:27]
    v_and_b32 v16, 7, v16
    v_xor_b32 v16, v16, v11
    v_lshl_add_u32 v12, v12, 3, v14
    v_lshlrev_b32 v12, 11, v12
    v_lshl_add_u32 v5, v16, 4, v12
    v_add_u32 v12, 24, v10
    v_cmp_le_u32 vcc, 17, v12
    v_subrev_u32 v13, 17, v12
    v_mov_b32 v14, s25
    v_cndmask_b32 v12, v12, v13, vcc
    v_addc_co_u32 v14, vcc, 0, v14, vcc
    v_mul_u32_u24 v16, 3, v12
    v_lshrrev_b64 v[16:17], v16, s[26:27]
    v_and_b32 v16, 7, v16
    v_xor_b32 v16, v16, v11
    v_lshl_add_u32 v12, v12, 3, v14
    v_lshlrev_b32 v12, 11, v12
    v_lshl_add_u32 v6, v16, 4, v12
    v_add_u32 v12, 32, v10
    v_cmp_le_u32 vcc, 17, v12
    v_subrev_u32 v13, 17, v12
    v_mov_b32 v14, s25
    v_cndmask_b32 v12, v12, v13, vcc
    v_addc_co_u32 v14, vcc, 0, v14, vcc
    v_mul_u32_u24 v16, 3, v12
    v_lshrrev_b64 v[16:17], v16, s[26:27]
    v_and_b32 v16, 7, v16
    v_xor_b32 v16, v16, v11
    v_lshl_add_u32 v12, v12, 3, v14
    v_lshlrev_b32 v12, 11, v12
    v_lshl_add_u32 v7, v16, 4, v12
    s_mul_i32 s48, s20, 4000
    s_lshl_b32 s50, s22, 8
    s_add_u32 s48, s48, s50
    s_lshl_b32 s48, s48, 10
    s_lshl_b32 s49, s21, 7
    s_mov_b32 s46, s48
    s_mov_b32 s47, s49
    s_and_b32 s55, s22, 7
    s_lshl_b32 s54, s55, 7
    s_add_u32 s48, s46, s54
    s_lshl_b32 s54, s55, 16
    s_add_u32 s49, s47, s54
    s_lshl_b32 s52, s24, 10
    s_mul_i32 s53, s24, 4352
    s_waitcnt lgkmcnt(0)
    s_mov_b32 s28, s4
    s_and_b32 s29, s5, 0xffff
    s_mov_b32 s30, 8192000
    s_mov_b32 s31, 0x00020000
    s_mov_b32 s32, s6
    s_and_b32 s33, s7, 0xffff
    s_mov_b32 s34, 7864320
    s_mov_b32 s35, 0x00020000
    s_add_u32 s54, s48, 0
    s_add_u32 m0, s53, 0
    s_nop 0
    buffer_load_dwordx4 v3, s[28:31], s54 offen lds
    s_add_u32 m0, s53, 1024
    s_nop 0
    buffer_load_dwordx4 v4, s[28:31], s54 offen lds
    s_add_u32 m0, s53, 2048
    s_nop 0
    buffer_load_dwordx4 v5, s[28:31], s54 offen lds
    s_add_u32 m0, s53, 3072
    s_nop 0
    buffer_load_dwordx4 v6, s[28:31], s54 offen lds
    s_add_u32 m0, s53, 4096
    s_mov_b64 exec, 0xffff
    buffer_load_dwordx4 v7, s[28:31], s54 offen lds
    s_mov_b64 exec, -1
    s_add_u32 m0, s52, 34816
    s_add_u32 s54, s49, 0
    buffer_load_dwordx4 v2, s[32:35], s54 offen lds
    s_add_u32 m0, s52, 38912
    s_add_u32 s54, s49, 1048576
    buffer_load_dwordx4 v2, s[32:35], s54 offen lds
    s_add_u32 m0, s52, 43008
    s_add_u32 s54, s49, 2097152
    buffer_load_dwordx4 v2, s[32:35], s54 offen lds
    s_add_u32 m0, s52, 47104
    s_add_u32 s54, s49, 3145728
    buffer_load_dwordx4 v2, s[32:35], s54 offen lds
    s_add_u32 m0, s52, 51200
    s_add_u32 s54, s49, 4194304
    buffer_load_dwordx4 v2, s[32:35], s54 offen lds
    s_add_u32 m0, s52, 55296
    s_add_u32 s54, s49, 5242880
    buffer_load_dwordx4 v2, s[32:35], s54 offen lds
    s_add_u32 m0, s52, 59392
    s_add_u32 s54, s49, 6291456
    buffer_load_dwordx4 v2, s[32:35], s54 offen lds
    s_add_u32 m0, s52, 63488
    s_add_u32 s54, s49, 7340032
    buffer_load_dwordx4 v2, s[32:35], s54 offen lds
    s_add_u32 m0, s52, 67584
    s_add_u32 s54, s49, 32768
    buffer_load_dwordx4 v2, s[32:35], s54 offen lds
    s_add_u32 m0, s52, 71680
    s_add_u32 s54, s49, 1081344
    buffer_load_dwordx4 v2, s[32:35], s54 offen lds
    s_add_u32 m0, s52, 75776
    s_add_u32 s54, s49, 2129920
    buffer_load_dwordx4 v2, s[32:35], s54 offen lds
    s_add_u32 m0, s52, 79872
    s_add_u32 s54, s49, 3178496
    buffer_load_dwordx4 v2, s[32:35], s54 offen lds
    s_add_u32 m0, s52, 83968
    s_add_u32 s54, s49, 4227072
    buffer_load_dwordx4 v2, s[32:35], s54 offen lds
    s_add_u32 m0, s52, 88064
    s_add_u32 s54, s49, 5275648
    buffer_load_dwordx4 v2, s[32:35], s54 offen lds
    s_add_u32 m0, s52, 92160
    s_add_u32 s54, s49, 6324224
    buffer_load_dwordx4 v2, s[32:35], s54 offen lds
    s_add_u32 m0, s52, 96256
    s_add_u32 s54, s49, 7372800
    buffer_load_dwordx4 v2, s[32:35], s54 offen lds
    s_waitcnt vmcnt(8)
    s_barrier
    s_add_u32 m0, s52, 100352
    s_add_u32 s54, s49, 524288
    buffer_load_dwordx4 v2, s[32:35], s54 offen lds
    s_add_u32 m0, s52, 104448
    s_add_u32 s54, s49, 1572864
    buffer_load_dwordx4 v2, s[32:35], s54 offen lds
    s_add_u32 m0, s52, 108544
    s_add_u32 s54, s49, 2621440
    buffer_load_dwordx4 v2, s[32:35], s54 offen lds
    s_add_u32 m0, s52, 112640
    s_add_u32 s54, s49, 3670016
    buffer_load_dwordx4 v2, s[32:35], s54 offen lds
    s_add_u32 m0, s52, 116736
    s_add_u32 s54, s49, 4718592
    buffer_load_dwordx4 v2, s[32:35], s54 offen lds
    s_add_u32 m0, s52, 120832
    s_add_u32 s54, s49, 5767168
    buffer_load_dwordx4 v2, s[32:35], s54 offen lds
    s_add_u32 m0, s52, 124928
    s_add_u32 s54, s49, 6815744
    buffer_load_dwordx4 v2, s[32:35], s54 offen lds
    s_waitcnt vmcnt(7)
    s_barrier
    s_add_u32 s54, s48, 1024
    s_add_u32 m0, s53, 17408
    s_nop 0
    buffer_load_dwordx4 v3, s[28:31], s54 offen lds
    s_add_u32 m0, s53, 18432
    s_nop 0
    buffer_load_dwordx4 v4, s[28:31], s54 offen lds
    s_add_u32 m0, s53, 19456
    s_nop 0
    buffer_load_dwordx4 v5, s[28:31], s54 offen lds
    s_add_u32 m0, s53, 20480
    s_nop 0
    buffer_load_dwordx4 v6, s[28:31], s54 offen lds
    s_add_u32 m0, s53, 21504
    s_mov_b64 exec, 0xffff
    buffer_load_dwordx4 v7, s[28:31], s54 offen lds
    s_mov_b64 exec, -1
    s_add_u32 m0, s52, 129024
    s_add_u32 s54, s49, 557056
    buffer_load_dwordx4 v2, s[32:35], s54 offen lds
    s_add_u32 m0, s52, 133120
    s_add_u32 s54, s49, 1605632
    buffer_load_dwordx4 v2, s[32:35], s54 offen lds
    s_add_u32 m0, s52, 137216
    s_add_u32 s54, s49, 2654208
    buffer_load_dwordx4 v2, s[32:35], s54 offen lds
    s_add_u32 m0, s52, 141312
    s_add_u32 s54, s49, 3702784
    buffer_load_dwordx4 v2, s[32:35], s54 offen lds
    s_add_u32 m0, s52, 145408
    s_add_u32 s54, s49, 4751360
    buffer_load_dwordx4 v2, s[32:35], s54 offen lds
    s_add_u32 m0, s52, 149504
    s_add_u32 s54, s49, 5799936
    buffer_load_dwordx4 v2, s[32:35], s54 offen lds
    s_add_u32 m0, s52, 153600
    s_add_u32 s54, s49, 6848512
    buffer_load_dwordx4 v2, s[32:35], s54 offen lds
    s_mov_b32 s50, 0
L_ploop:
    s_add_u32 s55, s55, 1
    s_and_b32 s55, s55, 7
    s_lshl_b32 s54, s55, 7
    s_add_u32 s48, s46, s54
    s_lshl_b32 s54, s55, 16
    s_add_u32 s49, s47, s54
    s_add_u32 m0, s52, 34816
    s_add_u32 s54, s49, 0
    buffer_load_dwordx4 v2, s[32:35], s54 offen lds
    s_add_u32 m0, s52, 38912
    s_add_u32 s54, s49, 1048576
    buffer_load_dwordx4 v2, s[32:35], s54 offen lds
    s_add_u32 m0, s52, 43008
    s_add_u32 s54, s49, 2097152
    buffer_load_dwordx4 v2, s[32:35], s54 offen lds
    s_add_u32 m0, s52, 47104
    s_add_u32 s54, s49, 3145728
    buffer_load_dwordx4 v2, s[32:35], s54 offen lds
    s_add_u32 m0, s52, 51200
    s_add_u32 s54, s49, 4194304
    buffer_load_dwordx4 v2, s[32:35], s54 offen lds
    s_add_u32 m0, s52, 55296
    s_add_u32 s54, s49, 5242880
    buffer_load_dwordx4 v2, s[32:35], s54 offen lds
    s_add_u32 m0, s52, 59392
    s_add_u32 s54, s49, 6291456
    buffer_load_dwordx4 v2, s[32:35], s54 offen lds
    s_add_u32 m0, s52, 63488
    s_add_u32 s54, s49, 7340032
    buffer_load_dwordx4 v2, s[32:35], s54 offen lds
    s_waitcnt vmcnt(15)
    s_barrier
    s_add_u32 s54, s48, 0
    s_add_u32 m0, s53, 0
    s_nop 0
    buffer_load_dwordx4 v3, s[28:31], s54 offen lds
    s_add_u32 m0, s53, 1024
    s_nop 0
    buffer_load_dwordx4 v4, s[28:31], s54 offen lds
    s_add_u32 m0, s53, 2048
    s_nop 0
    buffer_load_dwordx4 v5, s[28:31], s54 offen lds
    s_add_u32 m0, s53, 3072
    s_nop 0
    buffer_load_dwordx4 v6, s[28:31], s54 offen lds
    s_add_u32 m0, s53, 4096
    s_mov_b64 exec, 0xffff
    buffer_load_dwordx4 v7, s[28:31], s54 offen lds
    s_mov_b64 exec, -1
    s_add_u32 m0, s52, 67584
    s_add_u32 s54, s49, 32768
    buffer_load_dwordx4 v2, s[32:35], s54 offen lds
    s_add_u32 m0, s52, 71680
    s_add_u32 s54, s49, 1081344
    buffer_load_dwordx4 v2, s[32:35], s54 offen lds
    s_add_u32 m0, s52, 75776
    s_add_u32 s54, s49, 2129920
    buffer_load_dwordx4 v2, s[32:35], s54 offen lds
    s_add_u32 m0, s52, 79872
    s_add_u32 s54, s49, 3178496
    buffer_load_dwordx4 v2, s[32:35], s54 offen lds
    s_add_u32 m0, s52, 83968
    s_add_u32 s54, s49, 4227072
    buffer_load_dwordx4 v2, s[32:35], s54 offen lds
    s_add_u32 m0, s52, 88064
    s_add_u32 s54, s49, 5275648
    buffer_load_dwordx4 v2, s[32:35], s54 offen lds
    s_add_u32 m0, s52, 92160
    s_add_u32 s54, s49, 6324224
    buffer_load_dwordx4 v2, s[32:35], s54 offen lds
    s_add_u32 m0, s52, 96256
    s_add_u32 s54, s49, 7372800
    buffer_load_dwordx4 v2, s[32:35], s54 offen lds
    s_waitcnt vmcnt(21)
    s_barrier
    s_add_u32 m0, s52, 100352
    s_add_u32 s54, s49, 524288
    buffer_load_dwordx4 v2, s[32:35], s54 offen lds
    s_add_u32 m0, s52, 104448
    s_add_u32 s54, s49, 1572864
    buffer_load_dwordx4 v2, s[32:35], s54 offen lds
    s_add_u32 m0, s52, 108544
    s_add_u32 s54, s49, 2621440
    buffer_load_dwordx4 v2, s[32:35], s54 offen lds
    s_add_u32 m0, s52, 112640
    s_add_u32 s54, s49, 3670016
    buffer_load_dwordx4 v2, s[32:35], s54 offen lds
    s_add_u32 m0, s52, 116736
    s_add_u32 s54, s49, 4718592
    buffer_load_dwordx4 v2, s[32:35], s54 offen lds
    s_add_u32 m0, s52, 120832
    s_add_u32 s54, s49, 5767168
    buffer_load_dwordx4 v2, s[32:35], s54 offen lds
    s_add_u32 m0, s52, 124928
    s_add_u32 s54, s49, 6815744
    buffer_load_dwordx4 v2, s[32:35], s54 offen lds
    s_waitcnt vmcnt(15)
    s_barrier
    s_add_u32 s54, s48, 1024
    s_add_u32 m0, s53, 17408
    s_nop 0
    buffer_load_dwordx4 v3, s[28:31], s54 offen lds
    s_add_u32 m0, s53, 18432
    s_nop 0
    buffer_load_dwordx4 v4, s[28:31], s54 offen lds
    s_add_u32 m0, s53, 19456
    s_nop 0
    buffer_load_dwordx4 v5, s[28:31], s54 offen lds
    s_add_u32 m0, s53, 20480
    s_nop 0
    buffer_load_dwordx4 v6, s[28:31], s54 offen lds
    s_add_u32 m0, s53, 21504
    s_mov_b64 exec, 0xffff
    buffer_load_dwordx4 v7, s[28:31], s54 offen lds
    s_mov_b64 exec, -1
    s_add_u32 m0, s52, 129024
    s_add_u32 s54, s49, 557056
    buffer_load_dwordx4 v2, s[32:35], s54 offen lds
    s_add_u32 m0, s52, 133120
    s_add_u32 s54, s49, 1605632
    buffer_load_dwordx4 v2, s[32:35], s54 offen lds
    s_add_u32 m0, s52, 137216
    s_add_u32 s54, s49, 2654208
    buffer_load_dwordx4 v2, s[32:35], s54 offen lds
    s_add_u32 m0, s52, 141312
    s_add_u32 s54, s49, 3702784
    buffer_load_dwordx4 v2, s[32:35], s54 offen lds
    s_add_u32 m0, s52, 145408
    s_add_u32 s54, s49, 4751360
    buffer_load_dwordx4 v2, s[32:35], s54 offen lds
    s_add_u32 m0, s52, 149504
    s_add_u32 s54, s49, 5799936
    buffer_load_dwordx4 v2, s[32:35], s54 offen lds
    s_add_u32 m0, s52, 153600
    s_add_u32 s54, s49, 6848512
    buffer_load_dwordx4 v2, s[32:35], s54 offen lds
    s_add_u32 s50, s50, 1
    s_cmp_lt_u32 s50, 7
    s_waitcnt vmcnt(19)
    s_barrier
    s_cbranch_scc1 L_ploop
    s_waitcnt vmcnt(7)
    s_barrier
    s_waitcnt vmcnt(0)
    s_barrier
    s_endpgm
L_consumer:
    s_waitcnt lgkmcnt(0)
    s_mov_b32 s28, s4
    s_and_b32 s29, s5, 0xffff
    s_mov_b32 s30, 8192000
    s_mov_b32 s31, 0x00020000
    s_mov_b32 s32, s6
    s_and_b32 s33, s7, 0xffff
    s_mov_b32 s34, 7864320
    s_mov_b32 s35, 0x00020000
    v_and_b32 v10, 15, v0
    v_lshrrev_b32 v11, 4, v0
    s_mov_b32 s40, s18
    s_and_b32 s41, s19, 0xffff
    s_mov_b32 s42, 131072
    s_mov_b32 s43, 0x00020000
    s_lshl_b32 s56, s20, 3
    s_add_u32 s56, s56, s21
    s_lshl_b32 s57, s56, 13
    s_lshl_b32 s59, s23, 7
    s_add_u32 s57, s57, s59
    s_lshl_b32 s58, s22, 9
    s_add_u32 s58, s58, s57
    v_lshlrev_b32 v13, 5, v11
    v_lshl_add_u32 v240, v10, 4, v13
    v_lshl_add_u32 v241, v10, 9, v13
    v_mov_b32 v64, -1
    v_mov_b32 v65, -1
    v_mov_b32 v66, -1
    v_mov_b32 v67, -1
    s_mov_b32 exec_lo, 0x00030003
    s_mov_b32 exec_hi, 0x00030003
    buffer_store_dwordx4 v[64:67], v240, s[40:43], s58 offen sc1
    s_mov_b64 exec, -1
    s_lshl_b32 s48, s21, 7
    s_lshl_b32 s49, s23, 5
    s_add_u32 s48, s48, s49
    v_lshlrev_b32 v12, 3, v11
    v_add_u32 v12, s48, v12
    global_load_dwordx2 v[232:233], v12, s[8:9]
    global_load_dwordx2 v[234:235], v12, s[10:11]
    global_load_dwordx2 v[236:237], v12, s[12:13]
    s_and_b32 s60, s21, 3
    s_cmp_eq_u32 s60, 2
    s_cbranch_scc0 L_noppf
    s_and_b32 s62, s22, 7
    s_lshl_b32 s62, s62, 16
    s_xor_b32 s63, s21, 1
    s_lshl_b32 s63, s63, 7
    s_add_u32 s62, s62, s63
    s_lshr_b32 s63, s22, 3
    s_add_u32 s64, s23, 0
    s_lshl_b32 s64, s64, 7
    s_add_u32 s64, s64, s63
    v_lshl_add_u32 v13, v0, 1, s64
    v_subrev_u32 v14, 512, v13
    v_cmp_gt_u32 vcc, 512, v13
    v_mov_b32 v1, 224
    v_cmp_ge_i32 s[60:61], v14, v1
    v_lshrrev_b32 v15, 8, v13
    s_nop 0
    v_cndmask_b32 v246, 0, 1, s[60:61]
    v_cndmask_b32 v15, v246, v15, vcc
    v_mul_u32_u24 v246, 224, v246
    v_sub_u32 v14, v14, v246
    v_and_b32 v246, 255, v13
    v_cndmask_b32 v14, v14, v246, vcc
    v_cndmask_b32 v246, 1, 0, vcc
    v_lshrrev_b32 v247, 5, v14
    v_lshl_add_u32 v246, v247, 1, v246
    v_and_b32 v14, 31, v14
    v_lshl_add_u32 v14, v15, 5, v14
    v_lshlrev_b32 v14, 10, v14
    v_lshl_add_u32 v14, v246, 19, v14
    v_cmp_gt_u32 vcc, 960, v13
    v_mov_b32 v1, 0x7fffff00
    s_nop 0
    v_cndmask_b32 v14, v1, v14, vcc
    buffer_load_dword v238, v14, s[32:35], s62 offen
    s_add_u32 s64, s23, 4
    s_lshl_b32 s64, s64, 7
    s_add_u32 s64, s64, s63
    v_lshl_add_u32 v13, v0, 1, s64
    v_subrev_u32 v14, 512, v13
    v_cmp_gt_u32 vcc, 512, v13
    v_mov_b32 v1, 224
    v_cmp_ge_i32 s[60:61], v14, v1
    v_lshrrev_b32 v15, 8, v13
    s_nop 0
    v_cndmask_b32 v246, 0, 1, s[60:61]
    v_cndmask_b32 v15, v246, v15, vcc
    v_mul_u32_u24 v246, 224, v246
    v_sub_u32 v14, v14, v246
    v_and_b32 v246, 255, v13
    v_cndmask_b32 v14, v14, v246, vcc
    v_cndmask_b32 v246, 1, 0, vcc
    v_lshrrev_b32 v247, 5, v14
    v_lshl_add_u32 v246, v247, 1, v246
    v_and_b32 v14, 31, v14
    v_lshl_add_u32 v14, v15, 5, v14
    v_lshlrev_b32 v14, 10, v14
    v_lshl_add_u32 v14, v246, 19, v14
    v_cmp_gt_u32 vcc, 960, v13
    v_mov_b32 v1, 0x7fffff00
    s_nop 0
    v_cndmask_b32 v14, v1, v14, vcc
    buffer_load_dword v238, v14, s[32:35], s62 offen
L_noppf:
    v_add_u32 v13, 0, v10
    v_mul_u32_u24 v14, 3, v13
    v_lshrrev_b64 v[14:15], v14, s[26:27]
    v_and_b32 v14, 7, v14
    v_xor_b32 v14, v14, v11
    v_lshlrev_b32 v13, 7, v13
    v_lshl_add_u32 v2, v14, 4, v13
    v_xor_b32 v14, 4, v14
    v_lshl_add_u32 v3, v14, 4, v13
    v_add_u32 v13, 1, v10
    v_mul_u32_u24 v14, 3, v13
    v_lshrrev_b64 v[14:15], v14, s[26:27]
    v_and_b32 v14, 7, v14
    v_xor_b32 v14, v14, v11
    v_lshlrev_b32 v13, 7, v13
    v_lshl_add_u32 v4, v14, 4, v13
    v_xor_b32 v14, 4, v14
    v_lshl_add_u32 v5, v14, 4, v13
    v_lshrrev_b32 v13, 2, v10
    v_and_b32 v14, 3, v0
    v_lshrrev_b32 v15, 1, v13
    v_and_b32 v1, 1, v11
    v_lshl_or_b32 v15, v1, 1, v15
    v_xor_b32 v15, s23, v15
    v_lshl_add_u32 v13, v11, 3, v13
    v_lshlrev_b32 v13, 7, v13
    v_lshl_add_u32 v13, v15, 5, v13
    v_lshl_add_u32 v13, v14, 3, v13
    v_add_u32 v6, 34816, v13
    v_add_u32 v7, 67584, v13
    v_add_u32 v8, 100352, v13
    v_add_u32 v9, 129024, v13
    s_waitcnt vmcnt(2)
    v_lshlrev_b32 v13, 16, v232
    v_and_b32 v14, 0xffff0000, v232
    v_lshlrev_b32 v15, 16, v233
    v_and_b32 v1, 0xffff0000, v233
    v_mov_b32 v16, v13
    v_mov_b32 v17, v14
    v_mov_b32 v18, v15
    v_mov_b32 v19, v1
    v_mov_b32 v20, v13
    v_mov_b32 v21, v14
    v_mov_b32 v22, v15
    v_mov_b32 v23, v1
    v_mov_b32 v24, v13
    v_mov_b32 v25, v14
    v_mov_b32 v26, v15
    v_mov_b32 v27, v1
    v_mov_b32 v28, v13
    v_mov_b32 v29, v14
    v_mov_b32 v30, v15
    v_mov_b32 v31, v1
    v_mov_b32 v32, v13
    v_mov_b32 v33, v14
    v_mov_b32 v34, v15
    v_mov_b32 v35, v1
    v_mov_b32 v36, v13
    v_mov_b32 v37, v14
    v_mov_b32 v38, v15
    v_mov_b32 v39, v1
    v_mov_b32 v40, v13
    v_mov_b32 v41, v14
    v_mov_b32 v42, v15
    v_mov_b32 v43, v1
    v_mov_b32 v44, v13
    v_mov_b32 v45, v14
    v_mov_b32 v46, v15
    v_mov_b32 v47, v1
    s_lshl_b32 s59, s56, 2
    s_add_u32 s59, s59, 128
    v_mov_b32 v244, s59
    s_barrier
    ds_read_b64_tr_b16 v[168:169], v6 offset:0
    ds_read_b64_tr_b16 v[170:171], v6 offset:512
    ds_read_b128 v[48:51], v2 offset:0
    ds_read_b128 v[52:55], v2 offset:2176
    ds_read_b128 v[56:59], v2 offset:4352
    ds_read_b128 v[60:63], v2 offset:6528
    ds_read_b128 v[64:67], v2 offset:8704
    ds_read_b128 v[68:71], v2 offset:10880
    ds_read_b128 v[72:75], v2 offset:13056
    ds_read_b128 v[76:79], v2 offset:15232
    ds_read_b64_tr_b16 v[172:173], v6 offset:4096
    ds_read_b64_tr_b16 v[174:175], v6 offset:4608
    ds_read_b128 v[80:83], v4 offset:0
    ds_read_b64_tr_b16 v[176:177], v6 offset:8192
    ds_read_b64_tr_b16 v[178:179], v6 offset:8704
    ds_read_b128 v[84:87], v4 offset:2176
    ds_read_b64_tr_b16 v[180:181], v6 offset:12288
    ds_read_b64_tr_b16 v[182:183], v6 offset:12800
    ds_read_b128 v[88:91], v4 offset:4352
    ds_read_b64_tr_b16 v[184:185], v6 offset:16384
    ds_read_b64_tr_b16 v[186:187], v6 offset:16896
    ds_read_b128 v[92:95], v4 offset:6528
    ds_read_b64_tr_b16 v[188:189], v6 offset:20480
    ds_read_b64_tr_b16 v[190:191], v6 offset:20992
    ds_read_b128 v[96:99], v4 offset:8704
    ds_read_b64_tr_b16 v[192:193], v6 offset:24576
    ds_read_b64_tr_b16 v[194:195], v6 offset:25088
    ds_read_b128 v[100:103], v4 offset:10880
    ds_read_b64_tr_b16 v[196:197], v6 offset:28672
    ds_read_b64_tr_b16 v[198:199], v6 offset:29184
    ds_read_b128 v[104:107], v4 offset:13056
    s_cmp_eq_u32 s23, 0
    s_cbranch_scc0 L_nosig
    v_mov_b32 v15, 1
    s_mov_b64 exec, 1
    global_atomic_add v244, v15, s[16:17] sc1
    s_mov_b64 exec, -1
L_nosig:
    s_mov_b32 s50, 0
    s_waitcnt lgkmcnt(0)
    s_barrier
L_cloop:
    v_mfma_f32_16x16x32_bf16 v[16:19], v[168:171], v[48:51], v[16:19]
    ds_read_b64_tr_b16 v[200:201], v7 offset:0
    v_mfma_f32_16x16x32_bf16 v[16:19], v[172:175], v[52:55], v[16:19]
    ds_read_b64_tr_b16 v[202:203], v7 offset:512
    v_mfma_f32_16x16x32_bf16 v[16:19], v[176:179], v[56:59], v[16:19]
    v_mfma_f32_16x16x32_bf16 v[16:19], v[180:183], v[60:63], v[16:19]
    ds_read_b128 v[108:111], v3 offset:0
    v_mfma_f32_16x16x32_bf16 v[16:19], v[184:187], v[64:67], v[16:19]
    ds_read_b128 v[112:115], v3 offset:2176
    v_mfma_f32_16x16x32_bf16 v[16:19], v[188:191], v[68:71], v[16:19]
    v_mfma_f32_16x16x32_bf16 v[16:19], v[192:195], v[72:75], v[16:19]
    ds_read_b128 v[116:119], v3 offset:4352
    v_mfma_f32_16x16x32_bf16 v[16:19], v[196:199], v[76:79], v[16:19]
    ds_read_b128 v[120:123], v3 offset:6528
    v_mfma_f32_16x16x32_bf16 v[20:23], v[168:171], v[52:55], v[20:23]
    v_mfma_f32_16x16x32_bf16 v[20:23], v[172:175], v[56:59], v[20:23]
    ds_read_b128 v[124:127], v3 offset:8704
    v_mfma_f32_16x16x32_bf16 v[20:23], v[176:179], v[60:63], v[20:23]
    ds_read_b128 v[128:131], v3 offset:10880
    v_mfma_f32_16x16x32_bf16 v[20:23], v[180:183], v[64:67], v[20:23]
    v_mfma_f32_16x16x32_bf16 v[20:23], v[184:187], v[68:71], v[20:23]
    ds_read_b128 v[132:135], v3 offset:13056
    v_mfma_f32_16x16x32_bf16 v[20:23], v[188:191], v[72:75], v[20:23]
    ds_read_b128 v[136:139], v3 offset:15232
    v_mfma_f32_16x16x32_bf16 v[20:23], v[192:195], v[76:79], v[20:23]
    v_mfma_f32_16x16x32_bf16 v[20:23], v[196:199], v[80:83], v[20:23]
    ds_read_b64_tr_b16 v[204:205], v7 offset:4096
    v_mfma_f32_16x16x32_bf16 v[24:27], v[168:171], v[56:59], v[24:27]
    ds_read_b64_tr_b16 v[206:207], v7 offset:4608
    v_mfma_f32_16x16x32_bf16 v[24:27], v[172:175], v[60:63], v[24:27]
    v_mfma_f32_16x16x32_bf16 v[24:27], v[176:179], v[64:67], v[24:27]
    ds_read_b128 v[140:143], v5 offset:0
    v_mfma_f32_16x16x32_bf16 v[24:27], v[180:183], v[68:71], v[24:27]
    ds_read_b64_tr_b16 v[208:209], v7 offset:8192
    v_mfma_f32_16x16x32_bf16 v[24:27], v[184:187], v[72:75], v[24:27]
    v_mfma_f32_16x16x32_bf16 v[24:27], v[188:191], v[76:79], v[24:27]
    ds_read_b64_tr_b16 v[210:211], v7 offset:8704
    v_mfma_f32_16x16x32_bf16 v[24:27], v[192:195], v[80:83], v[24:27]
    ds_read_b128 v[144:147], v5 offset:2176
    v_mfma_f32_16x16x32_bf16 v[24:27], v[196:199], v[84:87], v[24:27]
    v_mfma_f32_16x16x32_bf16 v[28:31], v[168:171], v[60:63], v[28:31]
    ds_read_b64_tr_b16 v[212:213], v7 offset:12288
    v_mfma_f32_16x16x32_bf16 v[28:31], v[172:175], v[64:67], v[28:31]
    ds_read_b64_tr_b16 v[214:215], v7 offset:12800
    v_mfma_f32_16x16x32_bf16 v[28:31], v[176:179], v[68:71], v[28:31]
    v_mfma_f32_16x16x32_bf16 v[28:31], v[180:183], v[72:75], v[28:31]
    ds_read_b128 v[148:151], v5 offset:4352
    v_mfma_f32_16x16x32_bf16 v[28:31], v[184:187], v[76:79], v[28:31]
    ds_read_b64_tr_b16 v[216:217], v7 offset:16384
    v_mfma_f32_16x16x32_bf16 v[28:31], v[188:191], v[80:83], v[28:31]
    v_mfma_f32_16x16x32_bf16 v[28:31], v[192:195], v[84:87], v[28:31]
    ds_read_b64_tr_b16 v[218:219], v7 offset:16896
    v_mfma_f32_16x16x32_bf16 v[28:31], v[196:199], v[88:91], v[28:31]
    ds_read_b128 v[152:155], v5 offset:6528
    v_mfma_f32_16x16x32_bf16 v[32:35], v[168:171], v[64:67], v[32:35]
    v_mfma_f32_16x16x32_bf16 v[32:35], v[172:175], v[68:71], v[32:35]
    ds_read_b64_tr_b16 v[220:221], v7 offset:20480
    v_mfma_f32_16x16x32_bf16 v[32:35], v[176:179], v[72:75], v[32:35]
    ds_read_b64_tr_b16 v[222:223], v7 offset:20992
    v_mfma_f32_16x16x32_bf16 v[32:35], v[180:183], v[76:79], v[32:35]
    v_mfma_f32_16x16x32_bf16 v[32:35], v[184:187], v[80:83], v[32:35]
    ds_read_b128 v[156:159], v5 offset:8704
    v_mfma_f32_16x16x32_bf16 v[32:35], v[188:191], v[84:87], v[32:35]
    ds_read_b64_tr_b16 v[224:225], v7 offset:24576
    v_mfma_f32_16x16x32_bf16 v[32:35], v[192:195], v[88:91], v[32:35]
    v_mfma_f32_16x16x32_bf16 v[32:35], v[196:199], v[92:95], v[32:35]
    ds_read_b64_tr_b16 v[226:227], v7 offset:25088
    v_mfma_f32_16x16x32_bf16 v[36:39], v[168:171], v[68:71], v[36:39]
    ds_read_b128 v[160:163], v5 offset:10880
    v_mfma_f32_16x16x32_bf16 v[36:39], v[172:175], v[72:75], v[36:39]
    v_mfma_f32_16x16x32_bf16 v[36:39], v[176:179], v[76:79], v[36:39]
    ds_read_b64_tr_b16 v[228:229], v7 offset:28672
    v_mfma_f32_16x16x32_bf16 v[36:39], v[180:183], v[80:83], v[36:39]
    ds_read_b64_tr_b16 v[230:231], v7 offset:29184
    v_mfma_f32_16x16x32_bf16 v[36:39], v[184:187], v[84:87], v[36:39]
    v_mfma_f32_16x16x32_bf16 v[36:39], v[188:191], v[88:91], v[36:39]
    ds_read_b128 v[164:167], v5 offset:13056
    v_mfma_f32_16x16x32_bf16 v[36:39], v[192:195], v[92:95], v[36:39]
    v_mfma_f32_16x16x32_bf16 v[36:39], v[196:199], v[96:99], v[36:39]
    v_mfma_f32_16x16x32_bf16 v[40:43], v[168:171], v[72:75], v[40:43]
    v_mfma_f32_16x16x32_bf16 v[40:43], v[172:175], v[76:79], v[40:43]
    v_mfma_f32_16x16x32_bf16 v[40:43], v[176:179], v[80:83], v[40:43]
    v_mfma_f32_16x16x32_bf16 v[40:43], v[180:183], v[84:87], v[40:43]
    v_mfma_f32_16x16x32_bf16 v[40:43], v[184:187], v[88:91], v[40:43]
    v_mfma_f32_16x16x32_bf16 v[40:43], v[188:191], v[92:95], v[40:43]
    v_mfma_f32_16x16x32_bf16 v[40:43], v[192:195], v[96:99], v[40:43]
    v_mfma_f32_16x16x32_bf16 v[40:43], v[196:199], v[100:103], v[40:43]
    v_mfma_f32_16x16x32_bf16 v[44:47], v[168:171], v[76:79], v[44:47]
    v_mfma_f32_16x16x32_bf16 v[44:47], v[172:175], v[80:83], v[44:47]
    v_mfma_f32_16x16x32_bf16 v[44:47], v[176:179], v[84:87], v[44:47]
    v_mfma_f32_16x16x32_bf16 v[44:47], v[180:183], v[88:91], v[44:47]
    v_mfma_f32_16x16x32_bf16 v[44:47], v[184:187], v[92:95], v[44:47]
    v_mfma_f32_16x16x32_bf16 v[44:47], v[188:191], v[96:99], v[44:47]
    v_mfma_f32_16x16x32_bf16 v[44:47], v[192:195], v[100:103], v[44:47]
    v_mfma_f32_16x16x32_bf16 v[44:47], v[196:199], v[104:107], v[44:47]
    s_waitcnt lgkmcnt(0)
    s_barrier
    v_mfma_f32_16x16x32_bf16 v[16:19], v[200:203], v[108:111], v[16:19]
    ds_read_b64_tr_b16 v[168:169], v8 offset:0
    v_mfma_f32_16x16x32_bf16 v[16:19], v[204:207], v[112:115], v[16:19]
    ds_read_b64_tr_b16 v[170:171], v8 offset:512
    v_mfma_f32_16x16x32_bf16 v[16:19], v[208:211], v[116:119], v[16:19]
    v_mfma_f32_16x16x32_bf16 v[16:19], v[212:215], v[120:123], v[16:19]
    ds_read_b128 v[48:51], v2 offset:17408
    v_mfma_f32_16x16x32_bf16 v[16:19], v[216:219], v[124:127], v[16:19]
    ds_read_b128 v[52:55], v2 offset:19584
    v_mfma_f32_16x16x32_bf16 v[16:19], v[220:223], v[128:131], v[16:19]
    v_mfma_f32_16x16x32_bf16 v[16:19], v[224:227], v[132:135], v[16:19]
    ds_read_b128 v[56:59], v2 offset:21760
    v_mfma_f32_16x16x32_bf16 v[16:19], v[228:231], v[136:139], v[16:19]
    ds_read_b128 v[60:63], v2 offset:23936
    v_mfma_f32_16x16x32_bf16 v[20:23], v[200:203], v[112:115], v[20:23]
    v_mfma_f32_16x16x32_bf16 v[20:23], v[204:207], v[116:119], v[20:23]
    ds_read_b128 v[64:67], v2 offset:26112
    v_mfma_f32_16x16x32_bf16 v[20:23], v[208:211], v[120:123], v[20:23]
    ds_read_b128 v[68:71], v2 offset:28288
    v_mfma_f32_16x16x32_bf16 v[20:23], v[212:215], v[124:127], v[20:23]
    v_mfma_f32_16x16x32_bf16 v[20:23], v[216:219], v[128:131], v[20:23]
    ds_read_b128 v[72:75], v2 offset:30464
    v_mfma_f32_16x16x32_bf16 v[20:23], v[220:223], v[132:135], v[20:23]
    ds_read_b128 v[76:79], v2 offset:32640
    v_mfma_f32_16x16x32_bf16 v[20:23], v[224:227], v[136:139], v[20:23]
    v_mfma_f32_16x16x32_bf16 v[20:23], v[228:231], v[140:143], v[20:23]
    ds_read_b64_tr_b16 v[172:173], v8 offset:4096
    v_mfma_f32_16x16x32_bf16 v[24:27], v[200:203], v[116:119], v[24:27]
    ds_read_b64_tr_b16 v[174:175], v8 offset:4608
    v_mfma_f32_16x16x32_bf16 v[24:27], v[204:207], v[120:123], v[24:27]
    v_mfma_f32_16x16x32_bf16 v[24:27], v[208:211], v[124:127], v[24:27]
    ds_read_b128 v[80:83], v4 offset:17408
    v_mfma_f32_16x16x32_bf16 v[24:27], v[212:215], v[128:131], v[24:27]
    ds_read_b64_tr_b16 v[176:177], v8 offset:8192
    v_mfma_f32_16x16x32_bf16 v[24:27], v[216:219], v[132:135], v[24:27]
    v_mfma_f32_16x16x32_bf16 v[24:27], v[220:223], v[136:139], v[24:27]
    ds_read_b64_tr_b16 v[178:179], v8 offset:8704
    v_mfma_f32_16x16x32_bf16 v[24:27], v[224:227], v[140:143], v[24:27]
    ds_read_b128 v[84:87], v4 offset:19584
    v_mfma_f32_16x16x32_bf16 v[24:27], v[228:231], v[144:147], v[24:27]
    v_mfma_f32_16x16x32_bf16 v[28:31], v[200:203], v[120:123], v[28:31]
    ds_read_b64_tr_b16 v[180:181], v8 offset:12288
    v_mfma_f32_16x16x32_bf16 v[28:31], v[204:207], v[124:127], v[28:31]
    ds_read_b64_tr_b16 v[182:183], v8 offset:12800
    v_mfma_f32_16x16x32_bf16 v[28:31], v[208:211], v[128:131], v[28:31]
    v_mfma_f32_16x16x32_bf16 v[28:31], v[212:215], v[132:135], v[28:31]
    ds_read_b128 v[88:91], v4 offset:21760
    v_mfma_f32_16x16x32_bf16 v[28:31], v[216:219], v[136:139], v[28:31]
    ds_read_b64_tr_b16 v[184:185], v8 offset:16384
    v_mfma_f32_16x16x32_bf16 v[28:31], v[220:223], v[140:143], v[28:31]
    v_mfma_f32_16x16x32_bf16 v[28:31], v[224:227], v[144:147], v[28:31]
    ds_read_b64_tr_b16 v[186:187], v8 offset:16896
    v_mfma_f32_16x16x32_bf16 v[28:31], v[228:231], v[148:151], v[28:31]
    ds_read_b128 v[92:95], v4 offset:23936
    v_mfma_f32_16x16x32_bf16 v[32:35], v[200:203], v[124:127], v[32:35]
    v_mfma_f32_16x16x32_bf16 v[32:35], v[204:207], v[128:131], v[32:35]
    ds_read_b64_tr_b16 v[188:189], v8 offset:20480
    v_mfma_f32_16x16x32_bf16 v[32:35], v[208:211], v[132:135], v[32:35]
    ds_read_b64_tr_b16 v[190:191], v8 offset:20992
    v_mfma_f32_16x16x32_bf16 v[32:35], v[212:215], v[136:139], v[32:35]
    v_mfma_f32_16x16x32_bf16 v[32:35], v[216:219], v[140:143], v[32:35]
    ds_read_b128 v[96:99], v4 offset:26112
    v_mfma_f32_16x16x32_bf16 v[32:35], v[220:223], v[144:147], v[32:35]
    ds_read_b64_tr_b16 v[192:193], v8 offset:24576
    v_mfma_f32_16x16x32_bf16 v[32:35], v[224:227], v[148:151], v[32:35]
    v_mfma_f32_16x16x32_bf16 v[32:35], v[228:231], v[152:155], v[32:35]
    ds_read_b64_tr_b16 v[194:195], v8 offset:25088
    v_mfma_f32_16x16x32_bf16 v[36:39], v[200:203], v[128:131], v[36:39]
    ds_read_b128 v[100:103], v4 offset:28288
    v_mfma_f32_16x16x32_bf16 v[36:39], v[204:207], v[132:135], v[36:39]
    v_mfma_f32_16x16x32_bf16 v[36:39], v[208:211], v[136:139], v[36:39]
    v_mfma_f32_16x16x32_bf16 v[36:39], v[212:215], v[140:143], v[36:39]
    v_mfma_f32_16x16x32_bf16 v[36:39], v[216:219], v[144:147], v[36:39]
    v_mfma_f32_16x16x32_bf16 v[36:39], v[220:223], v[148:151], v[36:39]
    v_mfma_f32_16x16x32_bf16 v[36:39], v[224:227], v[152:155], v[36:39]
    v_mfma_f32_16x16x32_bf16 v[36:39], v[228:231], v[156:159], v[36:39]
    v_mfma_f32_16x16x32_bf16 v[40:43], v[200:203], v[132:135], v[40:43]
    v_mfma_f32_16x16x32_bf16 v[40:43], v[204:207], v[136:139], v[40:43]
    v_mfma_f32_16x16x32_bf16 v[40:43], v[208:211], v[140:143], v[40:43]
    v_mfma_f32_16x16x32_bf16 v[40:43], v[212:215], v[144:147], v[40:43]
    v_mfma_f32_16x16x32_bf16 v[40:43], v[216:219], v[148:151], v[40:43]
    v_mfma_f32_16x16x32_bf16 v[40:43], v[220:223], v[152:155], v[40:43]
    v_mfma_f32_16x16x32_bf16 v[40:43], v[224:227], v[156:159], v[40:43]
    v_mfma_f32_16x16x32_bf16 v[40:43], v[228:231], v[160:163], v[40:43]
    v_mfma_f32_16x16x32_bf16 v[44:47], v[200:203], v[136:139], v[44:47]
    v_mfma_f32_16x16x32_bf16 v[44:47], v[204:207], v[140:143], v[44:47]
    v_mfma_f32_16x16x32_bf16 v[44:47], v[208:211], v[144:147], v[44:47]
    v_mfma_f32_16x16x32_bf16 v[44:47], v[212:215], v[148:151], v[44:47]
    v_mfma_f32_16x16x32_bf16 v[44:47], v[216:219], v[152:155], v[44:47]
    v_mfma_f32_16x16x32_bf16 v[44:47], v[220:223], v[156:159], v[44:47]
    v_mfma_f32_16x16x32_bf16 v[44:47], v[224:227], v[160:163], v[44:47]
    v_mfma_f32_16x16x32_bf16 v[44:47], v[228:231], v[164:167], v[44:47]
    s_waitcnt lgkmcnt(0)
    s_barrier
    v_mfma_f32_16x16x32_bf16 v[16:19], v[168:171], v[48:51], v[16:19]
    ds_read_b64_tr_b16 v[200:201], v9 offset:0
    v_mfma_f32_16x16x32_bf16 v[16:19], v[172:175], v[52:55], v[16:19]
    ds_read_b64_tr_b16 v[202:203], v9 offset:512
    v_mfma_f32_16x16x32_bf16 v[16:19], v[176:179], v[56:59], v[16:19]
    v_mfma_f32_16x16x32_bf16 v[16:19], v[180:183], v[60:63], v[16:19]
    ds_read_b128 v[108:111], v3 offset:17408
    v_mfma_f32_16x16x32_bf16 v[16:19], v[184:187], v[64:67], v[16:19]
    ds_read_b128 v[112:115], v3 offset:19584
    v_mfma_f32_16x16x32_bf16 v[16:19], v[188:191], v[68:71], v[16:19]
    v_mfma_f32_16x16x32_bf16 v[16:19], v[192:195], v[72:75], v[16:19]
    ds_read_b128 v[116:119], v3 offset:21760
    v_mfma_f32_16x16x32_bf16 v[20:23], v[168:171], v[52:55], v[20:23]
    ds_read_b128 v[120:123], v3 offset:23936
    v_mfma_f32_16x16x32_bf16 v[20:23], v[172:175], v[56:59], v[20:23]
    v_mfma_f32_16x16x32_bf16 v[20:23], v[176:179], v[60:63], v[20:23]
    ds_read_b128 v[124:127], v3 offset:26112
    v_mfma_f32_16x16x32_bf16 v[20:23], v[180:183], v[64:67], v[20:23]
    ds_read_b128 v[128:131], v3 offset:28288
    v_mfma_f32_16x16x32_bf16 v[20:23], v[184:187], v[68:71], v[20:23]
    v_mfma_f32_16x16x32_bf16 v[20:23], v[188:191], v[72:75], v[20:23]
    ds_read_b128 v[132:135], v3 offset:30464
    v_mfma_f32_16x16x32_bf16 v[20:23], v[192:195], v[76:79], v[20:23]
    ds_read_b128 v[136:139], v3 offset:32640
    v_mfma_f32_16x16x32_bf16 v[24:27], v[168:171], v[56:59], v[24:27]
    v_mfma_f32_16x16x32_bf16 v[24:27], v[172:175], v[60:63], v[24:27]
    ds_read_b64_tr_b16 v[204:205], v9 offset:4096
    v_mfma_f32_16x16x32_bf16 v[24:27], v[176:179], v[64:67], v[24:27]
    ds_read_b64_tr_b16 v[206:207], v9 offset:4608
    v_mfma_f32_16x16x32_bf16 v[24:27], v[180:183], v[68:71], v[24:27]
    v_mfma_f32_16x16x32_bf16 v[24:27], v[184:187], v[72:75], v[24:27]
    ds_read_b128 v[140:143], v5 offset:17408
    v_mfma_f32_16x16x32_bf16 v[24:27], v[188:191], v[76:79], v[24:27]
    ds_read_b64_tr_b16 v[208:209], v9 offset:8192
    v_mfma_f32_16x16x32_bf16 v[24:27], v[192:195], v[80:83], v[24:27]
    v_mfma_f32_16x16x32_bf16 v[28:31], v[168:171], v[60:63], v[28:31]
    ds_read_b64_tr_b16 v[210:211], v9 offset:8704
    v_mfma_f32_16x16x32_bf16 v[28:31], v[172:175], v[64:67], v[28:31]
    ds_read_b128 v[144:147], v5 offset:19584
    v_mfma_f32_16x16x32_bf16 v[28:31], v[176:179], v[68:71], v[28:31]
    v_mfma_f32_16x16x32_bf16 v[28:31], v[180:183], v[72:75], v[28:31]
    ds_read_b64_tr_b16 v[212:213], v9 offset:12288
    v_mfma_f32_16x16x32_bf16 v[28:31], v[184:187], v[76:79], v[28:31]
    ds_read_b64_tr_b16 v[214:215], v9 offset:12800
    v_mfma_f32_16x16x32_bf16 v[28:31], v[188:191], v[80:83], v[28:31]
    v_mfma_f32_16x16x32_bf16 v[28:31], v[192:195], v[84:87], v[28:31]
    ds_read_b128 v[148:151], v5 offset:21760
    v_mfma_f32_16x16x32_bf16 v[32:35], v[168:171], v[64:67], v[32:35]
    ds_read_b64_tr_b16 v[216:217], v9 offset:16384
    v_mfma_f32_16x16x32_bf16 v[32:35], v[172:175], v[68:71], v[32:35]
    v_mfma_f32_16x16x32_bf16 v[32:35], v[176:179], v[72:75], v[32:35]
    ds_read_b64_tr_b16 v[218:219], v9 offset:16896
    v_mfma_f32_16x16x32_bf16 v[32:35], v[180:183], v[76:79], v[32:35]
    ds_read_b128 v[152:155], v5 offset:23936
    v_mfma_f32_16x16x32_bf16 v[32:35], v[184:187], v[80:83], v[32:35]
    v_mfma_f32_16x16x32_bf16 v[32:35], v[188:191], v[84:87], v[32:35]
    ds_read_b64_tr_b16 v[220:221], v9 offset:20480
    v_mfma_f32_16x16x32_bf16 v[32:35], v[192:195], v[88:91], v[32:35]
    ds_read_b64_tr_b16 v[222:223], v9 offset:20992
    v_mfma_f32_16x16x32_bf16 v[36:39], v[168:171], v[68:71], v[36:39]
    v_mfma_f32_16x16x32_bf16 v[36:39], v[172:175], v[72:75], v[36:39]
    ds_read_b128 v[156:159], v5 offset:26112
    v_mfma_f32_16x16x32_bf16 v[36:39], v[176:179], v[76:79], v[36:39]
    ds_read_b64_tr_b16 v[224:225], v9 offset:24576
    v_mfma_f32_16x16x32_bf16 v[36:39], v[180:183], v[80:83], v[36:39]
    v_mfma_f32_16x16x32_bf16 v[36:39], v[184:187], v[84:87], v[36:39]
    ds_read_b64_tr_b16 v[226:227], v9 offset:25088
    v_mfma_f32_16x16x32_bf16 v[36:39], v[188:191], v[88:91], v[36:39]
    ds_read_b128 v[160:163], v5 offset:28288
    v_mfma_f32_16x16x32_bf16 v[36:39], v[192:195], v[92:95], v[36:39]
    v_mfma_f32_16x16x32_bf16 v[40:43], v[168:171], v[72:75], v[40:43]
    v_mfma_f32_16x16x32_bf16 v[40:43], v[172:175], v[76:79], v[40:43]
    v_mfma_f32_16x16x32_bf16 v[40:43], v[176:179], v[80:83], v[40:43]
    v_mfma_f32_16x16x32_bf16 v[40:43], v[180:183], v[84:87], v[40:43]
    v_mfma_f32_16x16x32_bf16 v[40:43], v[184:187], v[88:91], v[40:43]
    v_mfma_f32_16x16x32_bf16 v[40:43], v[188:191], v[92:95], v[40:43]
    v_mfma_f32_16x16x32_bf16 v[40:43], v[192:195], v[96:99], v[40:43]
    v_mfma_f32_16x16x32_bf16 v[44:47], v[168:171], v[76:79], v[44:47]
    v_mfma_f32_16x16x32_bf16 v[44:47], v[172:175], v[80:83], v[44:47]
    v_mfma_f32_16x16x32_bf16 v[44:47], v[176:179], v[84:87], v[44:47]
    v_mfma_f32_16x16x32_bf16 v[44:47], v[180:183], v[88:91], v[44:47]
    v_mfma_f32_16x16x32_bf16 v[44:47], v[184:187], v[92:95], v[44:47]
    v_mfma_f32_16x16x32_bf16 v[44:47], v[188:191], v[96:99], v[44:47]
    v_mfma_f32_16x16x32_bf16 v[44:47], v[192:195], v[100:103], v[44:47]
    s_waitcnt lgkmcnt(0)
    s_barrier
    v_mfma_f32_16x16x32_bf16 v[16:19], v[200:203], v[108:111], v[16:19]
    ds_read_b64_tr_b16 v[168:169], v6 offset:0
    v_mfma_f32_16x16x32_bf16 v[16:19], v[204:207], v[112:115], v[16:19]
    ds_read_b64_tr_b16 v[170:171], v6 offset:512
    v_mfma_f32_16x16x32_bf16 v[16:19], v[208:211], v[116:119], v[16:19]
    v_mfma_f32_16x16x32_bf16 v[16:19], v[212:215], v[120:123], v[16:19]
    ds_read_b128 v[48:51], v2 offset:0
    v_mfma_f32_16x16x32_bf16 v[16:19], v[216:219], v[124:127], v[16:19]
    ds_read_b128 v[52:55], v2 offset:2176
    v_mfma_f32_16x16x32_bf16 v[16:19], v[220:223], v[128:131], v[16:19]
    v_mfma_f32_16x16x32_bf16 v[16:19], v[224:227], v[132:135], v[16:19]
    ds_read_b128 v[56:59], v2 offset:4352
    v_mfma_f32_16x16x32_bf16 v[20:23], v[200:203], v[112:115], v[20:23]
    ds_read_b128 v[60:63], v2 offset:6528
    v_mfma_f32_16x16x32_bf16 v[20:23], v[204:207], v[116:119], v[20:23]
    v_mfma_f32_16x16x32_bf16 v[20:23], v[208:211], v[120:123], v[20:23]
    ds_read_b128 v[64:67], v2 offset:8704
    v_mfma_f32_16x16x32_bf16 v[20:23], v[212:215], v[124:127], v[20:23]
    ds_read_b128 v[68:71], v2 offset:10880
    v_mfma_f32_16x16x32_bf16 v[20:23], v[216:219], v[128:131], v[20:23]
    v_mfma_f32_16x16x32_bf16 v[20:23], v[220:223], v[132:135], v[20:23]
    ds_read_b128 v[72:75], v2 offset:13056
    v_mfma_f32_16x16x32_bf16 v[20:23], v[224:227], v[136:139], v[20:23]
    ds_read_b128 v[76:79], v2 offset:15232
    v_mfma_f32_16x16x32_bf16 v[24:27], v[200:203], v[116:119], v[24:27]
    v_mfma_f32_16x16x32_bf16 v[24:27], v[204:207], v[120:123], v[24:27]
    ds_read_b64_tr_b16 v[172:173], v6 offset:4096
    v_mfma_f32_16x16x32_bf16 v[24:27], v[208:211], v[124:127], v[24:27]
    ds_read_b64_tr_b16 v[174:175], v6 offset:4608
    v_mfma_f32_16x16x32_bf16 v[24:27], v[212:215], v[128:131], v[24:27]
    v_mfma_f32_16x16x32_bf16 v[24:27], v[216:219], v[132:135], v[24:27]
    ds_read_b128 v[80:83], v4 offset:0
    v_mfma_f32_16x16x32_bf16 v[24:27], v[220:223], v[136:139], v[24:27]
    ds_read_b64_tr_b16 v[176:177], v6 offset:8192
    v_mfma_f32_16x16x32_bf16 v[24:27], v[224:227], v[140:143], v[24:27]
    v_mfma_f32_16x16x32_bf16 v[28:31], v[200:203], v[120:123], v[28:31]
    ds_read_b64_tr_b16 v[178:179], v6 offset:8704
    v_mfma_f32_16x16x32_bf16 v[28:31], v[204:207], v[124:127], v[28:31]
    ds_read_b128 v[84:87], v4 offset:2176
    v_mfma_f32_16x16x32_bf16 v[28:31], v[208:211], v[128:131], v[28:31]
    v_mfma_f32_16x16x32_bf16 v[28:31], v[212:215], v[132:135], v[28:31]
    ds_read_b64_tr_b16 v[180:181], v6 offset:12288
    v_mfma_f32_16x16x32_bf16 v[28:31], v[216:219], v[136:139], v[28:31]
    ds_read_b64_tr_b16 v[182:183], v6 offset:12800
    v_mfma_f32_16x16x32_bf16 v[28:31], v[220:223], v[140:143], v[28:31]
    v_mfma_f32_16x16x32_bf16 v[28:31], v[224:227], v[144:147], v[28:31]
    ds_read_b128 v[88:91], v4 offset:4352
    v_mfma_f32_16x16x32_bf16 v[32:35], v[200:203], v[124:127], v[32:35]
    ds_read_b64_tr_b16 v[184:185], v6 offset:16384
    v_mfma_f32_16x16x32_bf16 v[32:35], v[204:207], v[128:131], v[32:35]
    v_mfma_f32_16x16x32_bf16 v[32:35], v[208:211], v[132:135], v[32:35]
    ds_read_b64_tr_b16 v[186:187], v6 offset:16896
    v_mfma_f32_16x16x32_bf16 v[32:35], v[212:215], v[136:139], v[32:35]
    ds_read_b128 v[92:95], v4 offset:6528
    v_mfma_f32_16x16x32_bf16 v[32:35], v[216:219], v[140:143], v[32:35]
    v_mfma_f32_16x16x32_bf16 v[32:35], v[220:223], v[144:147], v[32:35]
    ds_read_b64_tr_b16 v[188:189], v6 offset:20480
    v_mfma_f32_16x16x32_bf16 v[32:35], v[224:227], v[148:151], v[32:35]
    ds_read_b64_tr_b16 v[190:191], v6 offset:20992
    v_mfma_f32_16x16x32_bf16 v[36:39], v[200:203], v[128:131], v[36:39]
    v_mfma_f32_16x16x32_bf16 v[36:39], v[204:207], v[132:135], v[36:39]
    ds_read_b128 v[96:99], v4 offset:8704
    v_mfma_f32_16x16x32_bf16 v[36:39], v[208:211], v[136:139], v[36:39]
    ds_read_b64_tr_b16 v[192:193], v6 offset:24576
    v_mfma_f32_16x16x32_bf16 v[36:39], v[212:215], v[140:143], v[36:39]
    v_mfma_f32_16x16x32_bf16 v[36:39], v[216:219], v[144:147], v[36:39]
    ds_read_b64_tr_b16 v[194:195], v6 offset:25088
    v_mfma_f32_16x16x32_bf16 v[36:39], v[220:223], v[148:151], v[36:39]
    ds_read_b128 v[100:103], v4 offset:10880
    v_mfma_f32_16x16x32_bf16 v[36:39], v[224:227], v[152:155], v[36:39]
    v_mfma_f32_16x16x32_bf16 v[40:43], v[200:203], v[132:135], v[40:43]
    ds_read_b64_tr_b16 v[196:197], v6 offset:28672
    v_mfma_f32_16x16x32_bf16 v[40:43], v[204:207], v[136:139], v[40:43]
    ds_read_b64_tr_b16 v[198:199], v6 offset:29184
    v_mfma_f32_16x16x32_bf16 v[40:43], v[208:211], v[140:143], v[40:43]
    v_mfma_f32_16x16x32_bf16 v[40:43], v[212:215], v[144:147], v[40:43]
    ds_read_b128 v[104:107], v4 offset:13056
    v_mfma_f32_16x16x32_bf16 v[40:43], v[216:219], v[148:151], v[40:43]
    v_mfma_f32_16x16x32_bf16 v[40:43], v[220:223], v[152:155], v[40:43]
    v_mfma_f32_16x16x32_bf16 v[40:43], v[224:227], v[156:159], v[40:43]
    v_mfma_f32_16x16x32_bf16 v[44:47], v[200:203], v[136:139], v[44:47]
    v_mfma_f32_16x16x32_bf16 v[44:47], v[204:207], v[140:143], v[44:47]
    v_mfma_f32_16x16x32_bf16 v[44:47], v[208:211], v[144:147], v[44:47]
    v_mfma_f32_16x16x32_bf16 v[44:47], v[212:215], v[148:151], v[44:47]
    v_mfma_f32_16x16x32_bf16 v[44:47], v[216:219], v[152:155], v[44:47]
    v_mfma_f32_16x16x32_bf16 v[44:47], v[220:223], v[156:159], v[44:47]
    v_mfma_f32_16x16x32_bf16 v[44:47], v[224:227], v[160:163], v[44:47]
    s_add_u32 s50, s50, 1
    s_cmp_lt_u32 s50, 8
    s_waitcnt lgkmcnt(0)
    s_barrier
    s_cbranch_scc1 L_cloop
    global_load_dword v245, v244, s[16:17] sc1
    s_lshl_b32 s51, s22, 7
    s_sub_u32 s52, 1993, s51
    v_lshlrev_b32 v13, 3, v10
    v_sub_u32 v13, s52, v13
    v_cmp_lt_i32 s[60:61], 0, v13
    v_cmp_lt_i32 s[62:63], 1, v13
    v_cmp_lt_i32 s[64:65], 2, v13
    v_cmp_lt_i32 s[66:67], 3, v13
    v_cmp_lt_i32 s[68:69], 4, v13
    v_cmp_lt_i32 s[70:71], 5, v13
    v_cmp_lt_i32 s[72:73], 6, v13
    v_cmp_lt_i32 s[74:75], 7, v13
    v_cmp_eq_u32 s[54:55], 1, v10
    s_mov_b32 s53, 0x3c000000
    s_cmp_eq_u32 s22, 15
    s_cbranch_scc0 L_nomask1
    s_mov_b32 s53, 0x3c607038
    v_cndmask_b32 v16, 0, v16, s[60:61]
    v_cndmask_b32 v17, 0, v17, s[60:61]
    v_cndmask_b32 v18, 0, v18, s[60:61]
    v_cndmask_b32 v19, 0, v19, s[60:61]
    v_cndmask_b32 v20, 0, v20, s[62:63]
    v_cndmask_b32 v21, 0, v21, s[62:63]
    v_cndmask_b32 v22, 0, v22, s[62:63]
    v_cndmask_b32 v23, 0, v23, s[62:63]
    v_cndmask_b32 v24, 0, v24, s[64:65]
    v_cndmask_b32 v25, 0, v25, s[64:65]
    v_cndmask_b32 v26, 0, v26, s[64:65]
    v_cndmask_b32 v27, 0, v27, s[64:65]
    v_cndmask_b32 v28, 0, v28, s[66:67]
    v_cndmask_b32 v29, 0, v29, s[66:67]
    v_cndmask_b32 v30, 0, v30, s[66:67]
    v_cndmask_b32 v31, 0, v31, s[66:67]
    v_cndmask_b32 v32, 0, v32, s[68:69]
    v_cndmask_b32 v33, 0, v33, s[68:69]
    v_cndmask_b32 v34, 0, v34, s[68:69]
    v_cndmask_b32 v35, 0, v35, s[68:69]
    v_cndmask_b32 v36, 0, v36, s[70:71]
    v_cndmask_b32 v37, 0, v37, s[70:71]
    v_cndmask_b32 v38, 0, v38, s[70:71]
    v_cndmask_b32 v39, 0, v39, s[70:71]
    v_cndmask_b32 v40, 0, v40, s[72:73]
    v_cndmask_b32 v41, 0, v41, s[72:73]
    v_cndmask_b32 v42, 0, v42, s[72:73]
    v_cndmask_b32 v43, 0, v43, s[72:73]
    v_cndmask_b32 v44, 0, v44, s[74:75]
    v_cndmask_b32 v45, 0, v45, s[74:75]
    v_cndmask_b32 v46, 0, v46, s[74:75]
    v_cndmask_b32 v47, 0, v47, s[74:75]
L_nomask1:
    v_pk_add_f32 v[48:49], v[16:17], v[20:21]
    v_pk_add_f32 v[50:51], v[18:19], v[22:23]
    v_pk_add_f32 v[60:61], v[24:25], v[28:29]
    v_pk_add_f32 v[62:63], v[26:27], v[30:31]
    v_pk_add_f32 v[52:53], v[32:33], v[36:37]
    v_pk_add_f32 v[54:55], v[34:35], v[38:39]
    v_pk_add_f32 v[56:57], v[40:41], v[44:45]
    v_pk_add_f32 v[58:59], v[42:43], v[46:47]
    v_pk_add_f32 v[48:49], v[48:49], v[60:61]
    v_pk_add_f32 v[50:51], v[50:51], v[62:63]
    v_pk_add_f32 v[52:53], v[52:53], v[56:57]
    v_pk_add_f32 v[54:55], v[54:55], v[58:59]
    v_pk_add_f32 v[48:49], v[48:49], v[52:53]
    v_pk_add_f32 v[50:51], v[50:51], v[54:55]
    s_nop 0
    v_add_f32_dpp v48, v48, v48 row_ror:8 row_mask:0xf bank_mask:0xf
    v_add_f32_dpp v49, v49, v49 row_ror:8 row_mask:0xf bank_mask:0xf
    v_add_f32_dpp v50, v50, v50 row_ror:8 row_mask:0xf bank_mask:0xf
    v_add_f32_dpp v51, v51, v51 row_ror:8 row_mask:0xf bank_mask:0xf
    v_add_f32_dpp v48, v48, v48 row_ror:4 row_mask:0xf bank_mask:0xf
    v_add_f32_dpp v49, v49, v49 row_ror:4 row_mask:0xf bank_mask:0xf
    v_add_f32_dpp v50, v50, v50 row_ror:4 row_mask:0xf bank_mask:0xf
    v_add_f32_dpp v51, v51, v51 row_ror:4 row_mask:0xf bank_mask:0xf
    v_add_f32_dpp v48, v48, v48 row_ror:2 row_mask:0xf bank_mask:0xf
    v_add_f32_dpp v49, v49, v49 row_ror:2 row_mask:0xf bank_mask:0xf
    v_add_f32_dpp v50, v50, v50 row_ror:2 row_mask:0xf bank_mask:0xf
    v_add_f32_dpp v51, v51, v51 row_ror:2 row_mask:0xf bank_mask:0xf
    v_add_f32_dpp v48, v48, v48 row_ror:1 row_mask:0xf bank_mask:0xf
    v_add_f32_dpp v49, v49, v49 row_ror:1 row_mask:0xf bank_mask:0xf
    v_add_f32_dpp v50, v50, v50 row_ror:1 row_mask:0xf bank_mask:0xf
    v_add_f32_dpp v51, v51, v51 row_ror:1 row_mask:0xf bank_mask:0xf
    v_mul_f32 v52, s53, v48
    v_mul_f32 v53, s53, v49
    v_mul_f32 v54, s53, v50
    v_mul_f32 v55, s53, v51
    s_cmp_eq_u32 s22, 15
    s_cbranch_scc0 L_nomask2
    v_cndmask_b32 v16, v52, v16, s[60:61]
    v_cndmask_b32 v17, v53, v17, s[60:61]
    v_cndmask_b32 v18, v54, v18, s[60:61]
    v_cndmask_b32 v19, v55, v19, s[60:61]
    v_cndmask_b32 v20, v52, v20, s[62:63]
    v_cndmask_b32 v21, v53, v21, s[62:63]
    v_cndmask_b32 v22, v54, v22, s[62:63]
    v_cndmask_b32 v23, v55, v23, s[62:63]
    v_cndmask_b32 v24, v52, v24, s[64:65]
    v_cndmask_b32 v25, v53, v25, s[64:65]
    v_cndmask_b32 v26, v54, v26, s[64:65]
    v_cndmask_b32 v27, v55, v27, s[64:65]
    v_cndmask_b32 v28, v52, v28, s[66:67]
    v_cndmask_b32 v29, v53, v29, s[66:67]
    v_cndmask_b32 v30, v54, v30, s[66:67]
    v_cndmask_b32 v31, v55, v31, s[66:67]
    v_cndmask_b32 v32, v52, v32, s[68:69]
    v_cndmask_b32 v33, v53, v33, s[68:69]
    v_cndmask_b32 v34, v54, v34, s[68:69]
    v_cndmask_b32 v35, v55, v35, s[68:69]
    v_cndmask_b32 v36, v52, v36, s[70:71]
    v_cndmask_b32 v37, v53, v37, s[70:71]
    v_cndmask_b32 v38, v54, v38, s[70:71]
    v_cndmask_b32 v39, v55, v39, s[70:71]
    v_cndmask_b32 v40, v52, v40, s[72:73]
    v_cndmask_b32 v41, v53, v41, s[72:73]
    v_cndmask_b32 v42, v54, v42, s[72:73]
    v_cndmask_b32 v43, v55, v43, s[72:73]
    v_cndmask_b32 v44, v52, v44, s[74:75]
    v_cndmask_b32 v45, v53, v45, s[74:75]
    v_cndmask_b32 v46, v54, v46, s[74:75]
    v_cndmask_b32 v47, v55, v47, s[74:75]
L_nomask2:
    v_pk_add_f32 v[60:61], v[16:17], v[52:53] neg_lo:[0,1] neg_hi:[0,1]
    v_pk_add_f32 v[62:63], v[18:19], v[54:55] neg_lo:[0,1] neg_hi:[0,1]
    v_pk_mul_f32 v[56:57], v[60:61], v[60:61]
    v_pk_mul_f32 v[58:59], v[62:63], v[62:63]
    v_pk_add_f32 v[60:61], v[20:21], v[52:53] neg_lo:[0,1] neg_hi:[0,1]
    v_pk_add_f32 v[62:63], v[22:23], v[54:55] neg_lo:[0,1] neg_hi:[0,1]
    v_pk_fma_f32 v[56:57], v[60:61], v[60:61], v[56:57]
    v_pk_fma_f32 v[58:59], v[62:63], v[62:63], v[58:59]
    v_pk_add_f32 v[60:61], v[24:25], v[52:53] neg_lo:[0,1] neg_hi:[0,1]
    v_pk_add_f32 v[62:63], v[26:27], v[54:55] neg_lo:[0,1] neg_hi:[0,1]
    v_pk_fma_f32 v[56:57], v[60:61], v[60:61], v[56:57]
    v_pk_fma_f32 v[58:59], v[62:63], v[62:63], v[58:59]
    v_pk_add_f32 v[60:61], v[28:29], v[52:53] neg_lo:[0,1] neg_hi:[0,1]
    v_pk_add_f32 v[62:63], v[30:31], v[54:55] neg_lo:[0,1] neg_hi:[0,1]
    v_pk_fma_f32 v[56:57], v[60:61], v[60:61], v[56:57]
    v_pk_fma_f32 v[58:59], v[62:63], v[62:63], v[58:59]
    v_pk_add_f32 v[60:61], v[32:33], v[52:53] neg_lo:[0,1] neg_hi:[0,1]
    v_pk_add_f32 v[62:63], v[34:35], v[54:55] neg_lo:[0,1] neg_hi:[0,1]
    v_pk_fma_f32 v[56:57], v[60:61], v[60:61], v[56:57]
    v_pk_fma_f32 v[58:59], v[62:63], v[62:63], v[58:59]
    v_pk_add_f32 v[60:61], v[36:37], v[52:53] neg_lo:[0,1] neg_hi:[0,1]
    v_pk_add_f32 v[62:63], v[38:39], v[54:55] neg_lo:[0,1] neg_hi:[0,1]
    v_pk_fma_f32 v[56:57], v[60:61], v[60:61], v[56:57]
    v_pk_fma_f32 v[58:59], v[62:63], v[62:63], v[58:59]
    v_pk_add_f32 v[60:61], v[40:41], v[52:53] neg_lo:[0,1] neg_hi:[0,1]
    v_pk_add_f32 v[62:63], v[42:43], v[54:55] neg_lo:[0,1] neg_hi:[0,1]
    v_pk_fma_f32 v[56:57], v[60:61], v[60:61], v[56:57]
    v_pk_fma_f32 v[58:59], v[62:63], v[62:63], v[58:59]
    v_pk_add_f32 v[60:61], v[44:45], v[52:53] neg_lo:[0,1] neg_hi:[0,1]
    v_pk_add_f32 v[62:63], v[46:47], v[54:55] neg_lo:[0,1] neg_hi:[0,1]
    v_pk_fma_f32 v[56:57], v[60:61], v[60:61], v[56:57]
    v_pk_fma_f32 v[58:59], v[62:63], v[62:63], v[58:59]
    s_nop 0
    v_add_f32_dpp v56, v56, v56 row_ror:8 row_mask:0xf bank_mask:0xf
    v_add_f32_dpp v57, v57, v57 row_ror:8 row_mask:0xf bank_mask:0xf
    v_add_f32_dpp v58, v58, v58 row_ror:8 row_mask:0xf bank_mask:0xf
    v_add_f32_dpp v59, v59, v59 row_ror:8 row_mask:0xf bank_mask:0xf
    v_add_f32_dpp v56, v56, v56 row_ror:4 row_mask:0xf bank_mask:0xf
    v_add_f32_dpp v57, v57, v57 row_ror:4 row_mask:0xf bank_mask:0xf
    v_add_f32_dpp v58, v58, v58 row_ror:4 row_mask:0xf bank_mask:0xf
    v_add_f32_dpp v59, v59, v59 row_ror:4 row_mask:0xf bank_mask:0xf
    v_add_f32_dpp v56, v56, v56 row_ror:2 row_mask:0xf bank_mask:0xf
    v_add_f32_dpp v57, v57, v57 row_ror:2 row_mask:0xf bank_mask:0xf
    v_add_f32_dpp v58, v58, v58 row_ror:2 row_mask:0xf bank_mask:0xf
    v_add_f32_dpp v59, v59, v59 row_ror:2 row_mask:0xf bank_mask:0xf
    v_add_f32_dpp v56, v56, v56 row_ror:1 row_mask:0xf bank_mask:0xf
    v_add_f32_dpp v57, v57, v57 row_ror:1 row_mask:0xf bank_mask:0xf
    v_add_f32_dpp v58, v58, v58 row_ror:1 row_mask:0xf bank_mask:0xf
    v_add_f32_dpp v59, v59, v59 row_ror:1 row_mask:0xf bank_mask:0xf
    v_cndmask_b32 v64, v48, v56, s[54:55]
    v_cndmask_b32 v65, v49, v57, s[54:55]
    v_cndmask_b32 v66, v50, v58, s[54:55]
    v_cndmask_b32 v67, v51, v59, s[54:55]
    v_min_u32 v64, -2, v64
    v_min_u32 v65, -2, v65
    v_min_u32 v66, -2, v66
    v_min_u32 v67, -2, v67
    s_mov_b32 exec_lo, 0x00030003
    s_mov_b32 exec_hi, 0x00030003
    buffer_store_dwordx4 v[64:67], v240, s[40:43], s58 offen sc1
    s_mov_b64 exec, -1
    v_cmp_eq_u32 s[54:55], 15, v10
    v_mov_b32 v76, 0x43000000
    v_mov_b32 v77, 0x42920000
    v_mov_b32 v78, 0x3c000000
    v_mov_b32 v79, 0x3c607038
    v_cndmask_b32 v76, v76, v77, s[54:55]
    v_cndmask_b32 v78, v78, v79, s[54:55]
    s_mul_i32 s44, s20, 2040832
    s_add_u32 s36, s14, s44
    s_addc_u32 s37, s15, 0
    s_and_b32 s37, s37, 0xffff
    s_mov_b32 s38, 2040832
    s_mov_b32 s39, 0x00020000
    s_mov_b32 s45, 0x3a038849
    s_mov_b32 s46, 0x3727c5ac
    v_lshlrev_b32 v100, 16, v234
    v_and_b32 v101, 0xffff0000, v234
    v_lshlrev_b32 v102, 16, v235
    v_and_b32 v103, 0xffff0000, v235
    v_lshlrev_b32 v104, 16, v236
    v_and_b32 v105, 0xffff0000, v236
    v_lshlrev_b32 v106, 16, v237
    v_and_b32 v107, 0xffff0000, v237
    v_lshlrev_b32 v13, 3, v10
    v_add_u32 v13, s51, v13
    v_lshlrev_b32 v13, 10, v13
    v_add_u32 v13, v13, v12
    s_mov_b32 s47, 4096
    v_mov_b32 v108, 0xbdd2d3e8
    v_mov_b32 v109, 0xbdd2d3e8
    v_mov_b32 v110, 0xc0135761
    v_mov_b32 v111, 0xc0135761
    v_mov_b32 v112, 1.0
    v_mov_b32 v113, 1.0
    v_mov_b32 v14, s46
    s_mov_b32 s76, 0x100000
    s_waitcnt vmcnt(1)
L_cpoll:
    v_readfirstlane_b32 s77, v245
    s_cmp_ge_u32 s77, 16
    s_cbranch_scc1 L_dstart
    s_sub_u32 s76, s76, 1
    s_cbranch_scc1 L_dstart
    s_sleep 2
    global_load_dword v245, v244, s[16:17] sc1
    s_waitcnt vmcnt(0)
    s_branch L_cpoll
L_dstart:
    s_mov_b32 s76, 0x100000
L_dpoll:
    buffer_load_dwordx4 v[68:71], v241, s[40:43], s57 offen sc1
    buffer_load_dwordx4 v[72:75], v241, s[40:43], s57 offen offset:16 sc1
    s_waitcnt vmcnt(0)
    v_max3_u32 v15, v68, v69, v70
    v_max3_u32 v1, v71, v72, v73
    v_max3_u32 v15, v15, v74, v75
    v_max_u32 v15, v15, v1
    v_cmp_eq_u32 vcc, -1, v15
    s_cbranch_vccz L_ddone
    s_sub_u32 s76, s76, 1
    s_cbranch_scc0 L_dpoll
L_ddone:
    v_mov_b32 v48, v68
    v_mov_b32 v49, v69
    v_mov_b32 v50, v70
    v_mov_b32 v51, v71
    v_add_f32_dpp v48, v48, v48 row_ror:8 row_mask:0xf bank_mask:0xf
    v_add_f32_dpp v49, v49, v49 row_ror:8 row_mask:0xf bank_mask:0xf
    v_add_f32_dpp v50, v50, v50 row_ror:8 row_mask:0xf bank_mask:0xf
    v_add_f32_dpp v51, v51, v51 row_ror:8 row_mask:0xf bank_mask:0xf
    v_add_f32_dpp v48, v48, v48 row_ror:4 row_mask:0xf bank_mask:0xf
    v_add_f32_dpp v49, v49, v49 row_ror:4 row_mask:0xf bank_mask:0xf
    v_add_f32_dpp v50, v50, v50 row_ror:4 row_mask:0xf bank_mask:0xf
    v_add_f32_dpp v51, v51, v51 row_ror:4 row_mask:0xf bank_mask:0xf
    v_add_f32_dpp v48, v48, v48 row_ror:2 row_mask:0xf bank_mask:0xf
    v_add_f32_dpp v49, v49, v49 row_ror:2 row_mask:0xf bank_mask:0xf
    v_add_f32_dpp v50, v50, v50 row_ror:2 row_mask:0xf bank_mask:0xf
    v_add_f32_dpp v51, v51, v51 row_ror:2 row_mask:0xf bank_mask:0xf
    v_add_f32_dpp v48, v48, v48 row_ror:1 row_mask:0xf bank_mask:0xf
    v_add_f32_dpp v49, v49, v49 row_ror:1 row_mask:0xf bank_mask:0xf
    v_add_f32_dpp v50, v50, v50 row_ror:1 row_mask:0xf bank_mask:0xf
    v_add_f32_dpp v51, v51, v51 row_ror:1 row_mask:0xf bank_mask:0xf
    v_mul_f32 v52, s45, v48
    v_mul_f32 v53, s45, v49
    v_mul_f32 v54, s45, v50
    v_mul_f32 v55, s45, v51
    v_fma_f32 v60, v68, v78, -v52
    v_fma_f32 v61, v69, v78, -v53
    v_fma_f32 v62, v70, v78, -v54
    v_fma_f32 v63, v71, v78, -v55
    v_mul_f32 v60, v60, v60
    v_mul_f32 v61, v61, v61
    v_mul_f32 v62, v62, v62
    v_mul_f32 v63, v63, v63
    v_fma_f32 v56, v60, v76, v72
    v_fma_f32 v57, v61, v76, v73
    v_fma_f32 v58, v62, v76, v74
    v_fma_f32 v59, v63, v76, v75
    v_add_f32_dpp v56, v56, v56 row_ror:8 row_mask:0xf bank_mask:0xf
    v_add_f32_dpp v57, v57, v57 row_ror:8 row_mask:0xf bank_mask:0xf
    v_add_f32_dpp v58, v58, v58 row_ror:8 row_mask:0xf bank_mask:0xf
    v_add_f32_dpp v59, v59, v59 row_ror:8 row_mask:0xf bank_mask:0xf
    v_add_f32_dpp v56, v56, v56 row_ror:4 row_mask:0xf bank_mask:0xf
    v_add_f32_dpp v57, v57, v57 row_ror:4 row_mask:0xf bank_mask:0xf
    v_add_f32_dpp v58, v58, v58 row_ror:4 row_mask:0xf bank_mask:0xf
    v_add_f32_dpp v59, v59, v59 row_ror:4 row_mask:0xf bank_mask:0xf
    v_add_f32_dpp v56, v56, v56 row_ror:2 row_mask:0xf bank_mask:0xf
    v_add_f32_dpp v57, v57, v57 row_ror:2 row_mask:0xf bank_mask:0xf
    v_add_f32_dpp v58, v58, v58 row_ror:2 row_mask:0xf bank_mask:0xf
    v_add_f32_dpp v59, v59, v59 row_ror:2 row_mask:0xf bank_mask:0xf
    v_add_f32_dpp v56, v56, v56 row_ror:1 row_mask:0xf bank_mask:0xf
    v_add_f32_dpp v57, v57, v57 row_ror:1 row_mask:0xf bank_mask:0xf
    v_add_f32_dpp v58, v58, v58 row_ror:1 row_mask:0xf bank_mask:0xf
    v_add_f32_dpp v59, v59, v59 row_ror:1 row_mask:0xf bank_mask:0xf
    v_fma_f32 v56, v56, s45, v14
    v_fma_f32 v57, v57, s45, v14
    v_fma_f32 v58, v58, s45, v14
    v_fma_f32 v59, v59, s45, v14
    v_rsq_f32 v56, v56
    v_rsq_f32 v57, v57
    v_rsq_f32 v58, v58
    v_rsq_f32 v59, v59
    s_nop 0
    v_mul_f32 v56, v56, v100
    v_mul_f32 v57, v57, v101
    v_mul_f32 v58, v58, v102
    v_mul_f32 v59, v59, v103
    v_fma_f32 v52, -v52, v56, v104
    v_fma_f32 v53, -v53, v57, v105
    v_fma_f32 v54, -v54, v58, v106
    v_fma_f32 v55, -v55, v59, v107
    v_pk_fma_f32 v[116:117], v[16:17], v[56:57], v[52:53]
    v_pk_fma_f32 v[118:119], v[18:19], v[58:59], v[54:55]
    v_pk_fma_f32 v[124:125], v[20:21], v[56:57], v[52:53]
    v_pk_fma_f32 v[126:127], v[22:23], v[58:59], v[54:55]
    v_pk_mul_f32 v[120:121], v[116:117], v[116:117]
    v_pk_mul_f32 v[122:123], v[118:119], v[118:119]
    v_pk_mul_f32 v[128:129], v[124:125], v[124:125]
    v_pk_mul_f32 v[130:131], v[126:127], v[126:127]
    v_pk_fma_f32 v[120:121], v[120:121], v[108:109], v[110:111]
    v_pk_fma_f32 v[122:123], v[122:123], v[108:109], v[110:111]
    v_pk_fma_f32 v[128:129], v[128:129], v[108:109], v[110:111]
    v_pk_fma_f32 v[130:131], v[130:131], v[108:109], v[110:111]
    v_pk_mul_f32 v[120:121], v[120:121], v[116:117]
    v_pk_mul_f32 v[122:123], v[122:123], v[118:119]
    v_pk_mul_f32 v[128:129], v[128:129], v[124:125]
    v_pk_mul_f32 v[130:131], v[130:131], v[126:127]
    v_exp_f32 v120, v120
    v_exp_f32 v121, v121
    v_exp_f32 v122, v122
    v_exp_f32 v123, v123
    v_exp_f32 v128, v128
    v_exp_f32 v129, v129
    v_exp_f32 v130, v130
    v_exp_f32 v131, v131
    v_pk_add_f32 v[120:121], v[120:121], v[112:113]
    v_pk_add_f32 v[122:123], v[122:123], v[112:113]
    v_pk_add_f32 v[128:129], v[128:129], v[112:113]
    v_pk_add_f32 v[130:131], v[130:131], v[112:113]
    v_rcp_f32 v120, v120
    v_rcp_f32 v121, v121
    v_rcp_f32 v122, v122
    v_rcp_f32 v123, v123
    v_rcp_f32 v128, v128
    v_rcp_f32 v129, v129
    v_rcp_f32 v130, v130
    v_rcp_f32 v131, v131
    v_pk_mul_f32 v[116:117], v[116:117], v[120:121]
    v_pk_mul_f32 v[118:119], v[118:119], v[122:123]
    v_pk_mul_f32 v[124:125], v[124:125], v[128:129]
    v_pk_mul_f32 v[126:127], v[126:127], v[130:131]
    v_cvt_pk_bf16_f32 v136, v116, v117
    v_cvt_pk_bf16_f32 v137, v118, v119
    buffer_store_dwordx2 v[136:137], v13, s[36:39], 0 offen offset:0
    v_cvt_pk_bf16_f32 v138, v124, v125
    v_cvt_pk_bf16_f32 v139, v126, v127
    buffer_store_dwordx2 v[138:139], v13, s[36:39], 0 offen offset:1024
    v_pk_fma_f32 v[116:117], v[24:25], v[56:57], v[52:53]
    v_pk_fma_f32 v[118:119], v[26:27], v[58:59], v[54:55]
    v_pk_fma_f32 v[124:125], v[28:29], v[56:57], v[52:53]
    v_pk_fma_f32 v[126:127], v[30:31], v[58:59], v[54:55]
    v_pk_mul_f32 v[120:121], v[116:117], v[116:117]
    v_pk_mul_f32 v[122:123], v[118:119], v[118:119]
    v_pk_mul_f32 v[128:129], v[124:125], v[124:125]
    v_pk_mul_f32 v[130:131], v[126:127], v[126:127]
    v_pk_fma_f32 v[120:121], v[120:121], v[108:109], v[110:111]
    v_pk_fma_f32 v[122:123], v[122:123], v[108:109], v[110:111]
    v_pk_fma_f32 v[128:129], v[128:129], v[108:109], v[110:111]
    v_pk_fma_f32 v[130:131], v[130:131], v[108:109], v[110:111]
    v_pk_mul_f32 v[120:121], v[120:121], v[116:117]
    v_pk_mul_f32 v[122:123], v[122:123], v[118:119]
    v_pk_mul_f32 v[128:129], v[128:129], v[124:125]
    v_pk_mul_f32 v[130:131], v[130:131], v[126:127]
    v_exp_f32 v120, v120
    v_exp_f32 v121, v121
    v_exp_f32 v122, v122
    v_exp_f32 v123, v123
    v_exp_f32 v128, v128
    v_exp_f32 v129, v129
    v_exp_f32 v130, v130
    v_exp_f32 v131, v131
    v_pk_add_f32 v[120:121], v[120:121], v[112:113]
    v_pk_add_f32 v[122:123], v[122:123], v[112:113]
    v_pk_add_f32 v[128:129], v[128:129], v[112:113]
    v_pk_add_f32 v[130:131], v[130:131], v[112:113]
    v_rcp_f32 v120, v120
    v_rcp_f32 v121, v121
    v_rcp_f32 v122, v122
    v_rcp_f32 v123, v123
    v_rcp_f32 v128, v128
    v_rcp_f32 v129, v129
    v_rcp_f32 v130, v130
    v_rcp_f32 v131, v131
    v_pk_mul_f32 v[116:117], v[116:117], v[120:121]
    v_pk_mul_f32 v[118:119], v[118:119], v[122:123]
    v_pk_mul_f32 v[124:125], v[124:125], v[128:129]
    v_pk_mul_f32 v[126:127], v[126:127], v[130:131]
    v_cvt_pk_bf16_f32 v140, v116, v117
    v_cvt_pk_bf16_f32 v141, v118, v119
    buffer_store_dwordx2 v[140:141], v13, s[36:39], 0 offen offset:2048
    v_cvt_pk_bf16_f32 v142, v124, v125
    v_cvt_pk_bf16_f32 v143, v126, v127
    buffer_store_dwordx2 v[142:143], v13, s[36:39], 0 offen offset:3072
    v_pk_fma_f32 v[116:117], v[32:33], v[56:57], v[52:53]
    v_pk_fma_f32 v[118:119], v[34:35], v[58:59], v[54:55]
    v_pk_fma_f32 v[124:125], v[36:37], v[56:57], v[52:53]
    v_pk_fma_f32 v[126:127], v[38:39], v[58:59], v[54:55]
    v_pk_mul_f32 v[120:121], v[116:117], v[116:117]
    v_pk_mul_f32 v[122:123], v[118:119], v[118:119]
    v_pk_mul_f32 v[128:129], v[124:125], v[124:125]
    v_pk_mul_f32 v[130:131], v[126:127], v[126:127]
    v_pk_fma_f32 v[120:121], v[120:121], v[108:109], v[110:111]
    v_pk_fma_f32 v[122:123], v[122:123], v[108:109], v[110:111]
    v_pk_fma_f32 v[128:129], v[128:129], v[108:109], v[110:111]
    v_pk_fma_f32 v[130:131], v[130:131], v[108:109], v[110:111]
    v_pk_mul_f32 v[120:121], v[120:121], v[116:117]
    v_pk_mul_f32 v[122:123], v[122:123], v[118:119]
    v_pk_mul_f32 v[128:129], v[128:129], v[124:125]
    v_pk_mul_f32 v[130:131], v[130:131], v[126:127]
    v_exp_f32 v120, v120
    v_exp_f32 v121, v121
    v_exp_f32 v122, v122
    v_exp_f32 v123, v123
    v_exp_f32 v128, v128
    v_exp_f32 v129, v129
    v_exp_f32 v130, v130
    v_exp_f32 v131, v131
    v_pk_add_f32 v[120:121], v[120:121], v[112:113]
    v_pk_add_f32 v[122:123], v[122:123], v[112:113]
    v_pk_add_f32 v[128:129], v[128:129], v[112:113]
    v_pk_add_f32 v[130:131], v[130:131], v[112:113]
    v_rcp_f32 v120, v120
    v_rcp_f32 v121, v121
    v_rcp_f32 v122, v122
    v_rcp_f32 v123, v123
    v_rcp_f32 v128, v128
    v_rcp_f32 v129, v129
    v_rcp_f32 v130, v130
    v_rcp_f32 v131, v131
    v_pk_mul_f32 v[116:117], v[116:117], v[120:121]
    v_pk_mul_f32 v[118:119], v[118:119], v[122:123]
    v_pk_mul_f32 v[124:125], v[124:125], v[128:129]
    v_pk_mul_f32 v[126:127], v[126:127], v[130:131]
    v_cvt_pk_bf16_f32 v144, v116, v117
    v_cvt_pk_bf16_f32 v145, v118, v119
    buffer_store_dwordx2 v[144:145], v13, s[36:39], s47 offen offset:0
    v_cvt_pk_bf16_f32 v146, v124, v125
    v_cvt_pk_bf16_f32 v147, v126, v127
    buffer_store_dwordx2 v[146:147], v13, s[36:39], s47 offen offset:1024
    v_pk_fma_f32 v[116:117], v[40:41], v[56:57], v[52:53]
    v_pk_fma_f32 v[118:119], v[42:43], v[58:59], v[54:55]
    v_pk_fma_f32 v[124:125], v[44:45], v[56:57], v[52:53]
    v_pk_fma_f32 v[126:127], v[46:47], v[58:59], v[54:55]
    v_pk_mul_f32 v[120:121], v[116:117], v[116:117]
    v_pk_mul_f32 v[122:123], v[118:119], v[118:119]
    v_pk_mul_f32 v[128:129], v[124:125], v[124:125]
    v_pk_mul_f32 v[130:131], v[126:127], v[126:127]
    v_pk_fma_f32 v[120:121], v[120:121], v[108:109], v[110:111]
    v_pk_fma_f32 v[122:123], v[122:123], v[108:109], v[110:111]
    v_pk_fma_f32 v[128:129], v[128:129], v[108:109], v[110:111]
    v_pk_fma_f32 v[130:131], v[130:131], v[108:109], v[110:111]
    v_pk_mul_f32 v[120:121], v[120:121], v[116:117]
    v_pk_mul_f32 v[122:123], v[122:123], v[118:119]
    v_pk_mul_f32 v[128:129], v[128:129], v[124:125]
    v_pk_mul_f32 v[130:131], v[130:131], v[126:127]
    v_exp_f32 v120, v120
    v_exp_f32 v121, v121
    v_exp_f32 v122, v122
    v_exp_f32 v123, v123
    v_exp_f32 v128, v128
    v_exp_f32 v129, v129
    v_exp_f32 v130, v130
    v_exp_f32 v131, v131
    v_pk_add_f32 v[120:121], v[120:121], v[112:113]
    v_pk_add_f32 v[122:123], v[122:123], v[112:113]
    v_pk_add_f32 v[128:129], v[128:129], v[112:113]
    v_pk_add_f32 v[130:131], v[130:131], v[112:113]
    v_rcp_f32 v120, v120
    v_rcp_f32 v121, v121
    v_rcp_f32 v122, v122
    v_rcp_f32 v123, v123
    v_rcp_f32 v128, v128
    v_rcp_f32 v129, v129
    v_rcp_f32 v130, v130
    v_rcp_f32 v131, v131
    v_pk_mul_f32 v[116:117], v[116:117], v[120:121]
    v_pk_mul_f32 v[118:119], v[118:119], v[122:123]
    v_pk_mul_f32 v[124:125], v[124:125], v[128:129]
    v_pk_mul_f32 v[126:127], v[126:127], v[130:131]
    v_cvt_pk_bf16_f32 v148, v116, v117
    v_cvt_pk_bf16_f32 v149, v118, v119
    buffer_store_dwordx2 v[148:149], v13, s[36:39], s47 offen offset:2048
    v_cvt_pk_bf16_f32 v150, v124, v125
    v_cvt_pk_bf16_f32 v151, v126, v127
    buffer_store_dwordx2 v[150:151], v13, s[36:39], s47 offen offset:3072
    s_endpgm
L_end:
    s_endpgm
.section .rodata,"a"
.p2align 6
.amdhsa_kernel standalone__self_sup_conv_stem_hubert__speech_kernel
  .amdhsa_next_free_vgpr 248
  .amdhsa_next_free_sgpr 102
  .amdhsa_accum_offset 248
  .amdhsa_group_segment_fixed_size 0
  .amdhsa_kernarg_size 64
  .amdhsa_user_sgpr_count 2
  .amdhsa_user_sgpr_kernarg_segment_ptr 1
  .amdhsa_system_sgpr_workgroup_id_x 1
  .amdhsa_float_denorm_mode_32 3
.end_amdhsa_kernel
```
